```python
import torch

def _softmax(x, axis=-1):
    return torch.softmax(x, dim=axis)
def _gelu(x):
    return torch.nn.functional.gelu(x, approximate="tanh")
def _silu(x):
    return torch.nn.functional.silu(x)
def _sigmoid(x):
    return torch.sigmoid(x)
def _layernorm(x, axis=-1, eps=1e-5):
    m = x.mean(dim=axis, keepdim=True)
    v = x.var(dim=axis, keepdim=True, unbiased=False)
    return (x - m) / torch.sqrt(v + eps)
def _scatter_add(tgt, idx, src, axis=0):
    return tgt.clone().index_add_(axis, idx, src)
def _segment_sum(src, seg, n):
    out = torch.zeros((n,) + src.shape[1:], dtype=src.dtype)
    return out.index_add_(0, seg, src)
def _pad(x, pw):
    flat = tuple(v for pair in reversed(pw) for v in pair)
    return torch.nn.functional.pad(x, flat)

kernel_name = 'concat_heads__mha_block_cached__gqa_block_cached__decode'

def setup_inputs():

    _w = (lambda a: (lambda t: t.to(torch.bfloat16) if t.is_floating_point() else t)(torch.as_tensor(a)))
    def _A_setup():
        B, Sq, D = 1, 1, 512
        H, Sk, Dh = 32, 8192, 128
        return {
            "x": _w((lambda *s: torch.randn(*s, dtype=torch.bfloat16) * 0.8)(B, Sq, D)),
            "k_cache": _w((lambda *s: torch.randn(*s, dtype=torch.bfloat16) * 0.8)(B, H, Sk, Dh)),
            "v_cache": _w((lambda *s: torch.randn(*s, dtype=torch.bfloat16) * 0.05)(B, H, Sk, Dh)),
            "wq": _w((lambda *s: torch.randn(*s, dtype=torch.bfloat16) * 0.8)(D, H * Dh) * (D ** -0.5)),
            "wo": _w((lambda *s: torch.randn(*s, dtype=torch.bfloat16) * 0.05)(H * Dh, D) * ((H * Dh) ** -0.5)),
        }
    _A_in = _A_setup()

    def _B_setup():
        B, Sq, D = 1, 1, 512
        Hq, Hkv, Sk, Dh = 32, 32, 8192, 128
        assert Hq % Hkv == 0, (Hq, Hkv)
        return {
            "x": _w((lambda *s: torch.randn(*s, dtype=torch.bfloat16) * 0.8)(B, Sq, D)),
            "k_cache": _w((lambda *s: torch.randn(*s, dtype=torch.bfloat16) * 0.8)(B, Hkv, Sk, Dh)),
            "v_cache": _w((lambda *s: torch.randn(*s, dtype=torch.bfloat16) * 0.05)(B, Hkv, Sk, Dh)),
            "wq": _w((lambda *s: torch.randn(*s, dtype=torch.bfloat16) * 0.8)(D, Hq * Dh) * (D ** -0.5)),
            "wo": _w((lambda *s: torch.randn(*s, dtype=torch.bfloat16) * 0.05)(Hq * Dh, D) * ((Hq * Dh) ** -0.5)),
        }
    _B_in = _B_setup()

    return {
        "A_x": _A_in["x"],
        "A_k_cache": _A_in["k_cache"],
        "A_v_cache": _A_in["v_cache"],
        "A_wq": _A_in["wq"],
        "A_wo": _A_in["wo"],
        "B_x": _B_in["x"],
        "B_k_cache": _B_in["k_cache"],
        "B_v_cache": _B_in["v_cache"],
        "B_wq": _B_in["wq"],
        "B_wo": _B_in["wo"],
    }

def reference(A_x, A_k_cache, A_v_cache, A_wq, A_wo, B_x, B_k_cache, B_v_cache, B_wq, B_wo):
    def _A_ref(x, k_cache, v_cache, wq, wo):
        B, Sq, D = x.shape
        H, Dh = 32, 128
        q = (lambda x, *d: x.permute(*d))((x @ wq).reshape(B, Sq, H, Dh), 0, 2, 1, 3)
        scores = torch.einsum("bhqd,bhkd->bhqk", q, k_cache) * (Dh ** -0.5)
        p = _softmax(scores, axis=-1)
        o = torch.einsum("bhqk,bhkd->bhqd", p, v_cache)
        return (lambda x, *d: x.permute(*d))(o, 0, 2, 1, 3).reshape(B, Sq, H * Dh) @ wo

    def _B_ref(x, k_cache, v_cache, wq, wo):
        B, Sq, D = x.shape
        Hq, Dh = 32, 128
        Hkv = k_cache.shape[1]
        rep = Hq // Hkv
        q = (lambda x, *d: x.permute(*d))((x @ wq).reshape(B, Sq, Hq, Dh), 0, 2, 1, 3)
        k = (lambda x, n, axis: torch.repeat_interleave(x, n, dim=axis))(k_cache, rep, axis=1)
        v = (lambda x, n, axis: torch.repeat_interleave(x, n, dim=axis))(v_cache, rep, axis=1)
        scores = torch.einsum("bhqd,bhkd->bhqk", q, k) * (Dh ** -0.5)
        p = _softmax(scores, axis=-1)
        o = torch.einsum("bhqk,bhkd->bhqd", p, v)
        return (lambda x, *d: x.permute(*d))(o, 0, 2, 1, 3).reshape(B, Sq, Hq * Dh) @ wo

    a = _A_ref(A_x, A_k_cache, A_v_cache, A_wq, A_wo)
    b = _B_ref(B_x, B_k_cache, B_v_cache, B_wq, B_wo)
    return torch.concatenate([a, b], axis=-1)
```

```asm
; @launch kernel=concat_heads__mha_block_cached__gqa_block_cached__decode_kernel grid=(256,1,1) block=(512,1,1) lds=27648
; @launch kernel=concat_heads_combine_kernel grid=(32,1,1) block=(256,1,1) lds=4096
.amdgcn_target "amdgcn-amd-amdhsa--gfx950"
.text
.globl concat_heads__mha_block_cached__gqa_block_cached__decode_kernel
.p2align 8
.type concat_heads__mha_block_cached__gqa_block_cached__decode_kernel,@function
concat_heads__mha_block_cached__gqa_block_cached__decode_kernel:
    s_cmp_ge_u32 s2, 256
    s_cbranch_scc1 L_k1_end
    s_and_b32 s3, s2, 7
    s_lshr_b32 s4, s2, 3
    s_and_b32 s5, s4, 3
    s_lshr_b32 s4, s2, 5
    s_lshl_b32 s4, s4, 3
    s_add_u32 s4, s4, s3
    s_lshr_b32 s6, s4, 5
    s_and_b32 s7, s4, 31
    s_mul_i32 s8, s6, 40
    s_load_dwordx4 s[12:15], s[0:1], s8
    s_load_dwordx4 s[16:19], s[0:1], s8 offset:16
    s_load_dwordx2 s[20:21], s[0:1], s8 offset:32
    s_load_dwordx2 s[22:23], s[0:1], 96
    v_lshrrev_b32 v18, 4, v0
    v_lshlrev_b32 v19, 5, v18
    v_lshlrev_b32 v18, 17, v18
    v_and_b32 v3, 15, v0
    v_lshl_add_u32 v18, v3, 4, v18
    v_and_b32 v17, 63, v0
    v_lshlrev_b32 v17, 4, v17
    v_lshrrev_b32 v16, 6, v0
    v_lshl_add_u32 v1, v16, 12, v17
    v_lshl_add_u32 v2, v16, 14, v17
    s_lshl_b32 s48, s7, 21
    s_lshl_b32 s49, s5, 19
    s_add_u32 s50, s48, s49
    s_mov_b32 s52, 0
    s_lshl_b32 s60, s7, 8
    s_lshl_b32 s68, s7, 17
    s_mov_b32 s70, 0x3e0293ee
    s_lshl_b32 s71, s4, 2
    s_add_u32 s71, s71, s5
    s_lshl_b32 s72, s71, 11
    s_lshl_b32 s73, s71, 3
    s_add_u32 s73, s73, 524288
    s_mov_b32 s74, 0x05040100
    s_mov_b32 s75, 0x07060302
    s_waitcnt lgkmcnt(0)
    s_mov_b32 s24, s12
    s_mov_b32 s25, s13
    s_mov_b32 s26, 1024
    s_mov_b32 s27, 0x00020000
    s_mov_b32 s36, s18
    s_mov_b32 s37, s19
    s_mov_b32 s38, 4194304
    s_mov_b32 s39, 0x00020000
    buffer_load_dwordx4 v[20:23], v19, s[24:27], 0 offen offset:0
    buffer_load_dwordx4 v[24:27], v19, s[24:27], 0 offen offset:16
    buffer_load_dwordx4 v[32:35], v18, s[36:39], s60 offen
    s_add_u32 s60, s60, 8192
    buffer_load_dwordx4 v[36:39], v18, s[36:39], s60 offen
    s_add_u32 s60, s60, 8192
    buffer_load_dwordx4 v[40:43], v18, s[36:39], s60 offen
    s_add_u32 s60, s60, 8192
    buffer_load_dwordx4 v[44:47], v18, s[36:39], s60 offen
    s_add_u32 s60, s60, 8192
    buffer_load_dwordx4 v[48:51], v18, s[36:39], s60 offen
    s_add_u32 s60, s60, 8192
    buffer_load_dwordx4 v[52:55], v18, s[36:39], s60 offen
    s_add_u32 s60, s60, 8192
    buffer_load_dwordx4 v[56:59], v18, s[36:39], s60 offen
    s_add_u32 s60, s60, 8192
    buffer_load_dwordx4 v[60:63], v18, s[36:39], s60 offen
    s_add_u32 s60, s60, 8192
    buffer_load_dwordx4 v[64:67], v18, s[36:39], s60 offen
    s_add_u32 s60, s60, 8192
    buffer_load_dwordx4 v[68:71], v18, s[36:39], s60 offen
    s_add_u32 s60, s60, 8192
    buffer_load_dwordx4 v[72:75], v18, s[36:39], s60 offen
    s_add_u32 s60, s60, 8192
    buffer_load_dwordx4 v[76:79], v18, s[36:39], s60 offen
    s_add_u32 s60, s60, 8192
    buffer_load_dwordx4 v[80:83], v18, s[36:39], s60 offen
    s_add_u32 s60, s60, 8192
    buffer_load_dwordx4 v[84:87], v18, s[36:39], s60 offen
    s_add_u32 s60, s60, 8192
    buffer_load_dwordx4 v[88:91], v18, s[36:39], s60 offen
    s_add_u32 s60, s60, 8192
    buffer_load_dwordx4 v[92:95], v18, s[36:39], s60 offen
    s_mov_b32 s28, s14
    s_mov_b32 s29, s15
    s_mov_b32 s30, 67108864
    s_mov_b32 s31, 0x00020000
    s_mov_b32 s32, s16
    s_mov_b32 s33, s17
    s_mov_b32 s34, 67108864
    s_mov_b32 s35, 0x00020000
    s_mov_b32 s40, s20
    s_mov_b32 s41, s21
    s_mov_b32 s42, 4194304
    s_mov_b32 s43, 0x00020000
    s_mov_b32 s44, s22
    s_mov_b32 s45, s23
    s_mov_b32 s46, 526336
    s_mov_b32 s47, 0x00020000
    s_add_u32 s53, s52, 0
    s_and_b32 s53, s53, 15
    s_mul_i32 s53, s53, 32768
    s_add_u32 s53, s53, s50
    buffer_load_dwordx4 v[96:99], v1, s[28:31], s53 offen offset:0 nt
    buffer_load_dwordx4 v[100:103], v1, s[28:31], s53 offen offset:1024 nt
    buffer_load_dwordx4 v[104:107], v1, s[28:31], s53 offen offset:2048 nt
    buffer_load_dwordx4 v[108:111], v1, s[28:31], s53 offen offset:3072 nt
    s_add_u32 s53, s52, 0
    s_and_b32 s53, s53, 15
    s_mul_i32 s53, s53, 32768
    s_add_u32 s53, s53, s50
    buffer_load_dwordx4 v[112:115], v1, s[32:35], s53 offen offset:0 nt
    buffer_load_dwordx4 v[116:119], v1, s[32:35], s53 offen offset:1024 nt
    buffer_load_dwordx4 v[120:123], v1, s[32:35], s53 offen offset:2048 nt
    buffer_load_dwordx4 v[124:127], v1, s[32:35], s53 offen offset:3072 nt
    s_add_u32 s53, s52, 1
    s_and_b32 s53, s53, 15
    s_mul_i32 s53, s53, 32768
    s_add_u32 s53, s53, s50
    buffer_load_dwordx4 v[128:131], v1, s[28:31], s53 offen offset:0 nt
    buffer_load_dwordx4 v[132:135], v1, s[28:31], s53 offen offset:1024 nt
    buffer_load_dwordx4 v[136:139], v1, s[28:31], s53 offen offset:2048 nt
    buffer_load_dwordx4 v[140:143], v1, s[28:31], s53 offen offset:3072 nt
    s_add_u32 s53, s52, 1
    s_and_b32 s53, s53, 15
    s_mul_i32 s53, s53, 32768
    s_add_u32 s53, s53, s50
    buffer_load_dwordx4 v[144:147], v1, s[32:35], s53 offen offset:0 nt
    buffer_load_dwordx4 v[148:151], v1, s[32:35], s53 offen offset:1024 nt
    buffer_load_dwordx4 v[152:155], v1, s[32:35], s53 offen offset:2048 nt
    buffer_load_dwordx4 v[156:159], v1, s[32:35], s53 offen offset:3072 nt
    s_waitcnt vmcnt(16)
    v_and_b32 v4, 0xffff, v20
    v_lshlrev_b32 v5, 16, v20
    v_dot2_f32_bf16 v8, v4, v32, 0
    v_dot2_f32_bf16 v9, v5, v32, 0
    v_dot2_f32_bf16 v10, v4, v33, 0
    v_dot2_f32_bf16 v11, v5, v33, 0
    v_dot2_f32_bf16 v12, v4, v34, 0
    v_dot2_f32_bf16 v13, v5, v34, 0
    v_dot2_f32_bf16 v14, v4, v35, 0
    v_dot2_f32_bf16 v15, v5, v35, 0
    v_lshrrev_b32 v6, 16, v20
    v_and_b32 v7, 0xffff0000, v20
    v_dot2_f32_bf16 v8, v6, v36, v8
    v_dot2_f32_bf16 v9, v7, v36, v9
    v_dot2_f32_bf16 v10, v6, v37, v10
    v_dot2_f32_bf16 v11, v7, v37, v11
    v_dot2_f32_bf16 v12, v6, v38, v12
    v_dot2_f32_bf16 v13, v7, v38, v13
    v_dot2_f32_bf16 v14, v6, v39, v14
    v_dot2_f32_bf16 v15, v7, v39, v15
    v_and_b32 v4, 0xffff, v21
    v_lshlrev_b32 v5, 16, v21
    v_dot2_f32_bf16 v8, v4, v40, v8
    v_dot2_f32_bf16 v9, v5, v40, v9
    v_dot2_f32_bf16 v10, v4, v41, v10
    v_dot2_f32_bf16 v11, v5, v41, v11
    v_dot2_f32_bf16 v12, v4, v42, v12
    v_dot2_f32_bf16 v13, v5, v42, v13
    v_dot2_f32_bf16 v14, v4, v43, v14
    v_dot2_f32_bf16 v15, v5, v43, v15
    v_lshrrev_b32 v6, 16, v21
    v_and_b32 v7, 0xffff0000, v21
    v_dot2_f32_bf16 v8, v6, v44, v8
    v_dot2_f32_bf16 v9, v7, v44, v9
    v_dot2_f32_bf16 v10, v6, v45, v10
    v_dot2_f32_bf16 v11, v7, v45, v11
    v_dot2_f32_bf16 v12, v6, v46, v12
    v_dot2_f32_bf16 v13, v7, v46, v13
    v_dot2_f32_bf16 v14, v6, v47, v14
    v_dot2_f32_bf16 v15, v7, v47, v15
    v_and_b32 v4, 0xffff, v22
    v_lshlrev_b32 v5, 16, v22
    v_dot2_f32_bf16 v8, v4, v48, v8
    v_dot2_f32_bf16 v9, v5, v48, v9
    v_dot2_f32_bf16 v10, v4, v49, v10
    v_dot2_f32_bf16 v11, v5, v49, v11
    v_dot2_f32_bf16 v12, v4, v50, v12
    v_dot2_f32_bf16 v13, v5, v50, v13
    v_dot2_f32_bf16 v14, v4, v51, v14
    v_dot2_f32_bf16 v15, v5, v51, v15
    v_lshrrev_b32 v6, 16, v22
    v_and_b32 v7, 0xffff0000, v22
    v_dot2_f32_bf16 v8, v6, v52, v8
    v_dot2_f32_bf16 v9, v7, v52, v9
    v_dot2_f32_bf16 v10, v6, v53, v10
    v_dot2_f32_bf16 v11, v7, v53, v11
    v_dot2_f32_bf16 v12, v6, v54, v12
    v_dot2_f32_bf16 v13, v7, v54, v13
    v_dot2_f32_bf16 v14, v6, v55, v14
    v_dot2_f32_bf16 v15, v7, v55, v15
    v_and_b32 v4, 0xffff, v23
    v_lshlrev_b32 v5, 16, v23
    v_dot2_f32_bf16 v8, v4, v56, v8
    v_dot2_f32_bf16 v9, v5, v56, v9
    v_dot2_f32_bf16 v10, v4, v57, v10
    v_dot2_f32_bf16 v11, v5, v57, v11
    v_dot2_f32_bf16 v12, v4, v58, v12
    v_dot2_f32_bf16 v13, v5, v58, v13
    v_dot2_f32_bf16 v14, v4, v59, v14
    v_dot2_f32_bf16 v15, v5, v59, v15
    v_lshrrev_b32 v6, 16, v23
    v_and_b32 v7, 0xffff0000, v23
    v_dot2_f32_bf16 v8, v6, v60, v8
    v_dot2_f32_bf16 v9, v7, v60, v9
    v_dot2_f32_bf16 v10, v6, v61, v10
    v_dot2_f32_bf16 v11, v7, v61, v11
    v_dot2_f32_bf16 v12, v6, v62, v12
    v_dot2_f32_bf16 v13, v7, v62, v13
    v_dot2_f32_bf16 v14, v6, v63, v14
    v_dot2_f32_bf16 v15, v7, v63, v15
    v_and_b32 v4, 0xffff, v24
    v_lshlrev_b32 v5, 16, v24
    v_dot2_f32_bf16 v8, v4, v64, v8
    v_dot2_f32_bf16 v9, v5, v64, v9
    v_dot2_f32_bf16 v10, v4, v65, v10
    v_dot2_f32_bf16 v11, v5, v65, v11
    v_dot2_f32_bf16 v12, v4, v66, v12
    v_dot2_f32_bf16 v13, v5, v66, v13
    v_dot2_f32_bf16 v14, v4, v67, v14
    v_dot2_f32_bf16 v15, v5, v67, v15
    v_lshrrev_b32 v6, 16, v24
    v_and_b32 v7, 0xffff0000, v24
    v_dot2_f32_bf16 v8, v6, v68, v8
    v_dot2_f32_bf16 v9, v7, v68, v9
    v_dot2_f32_bf16 v10, v6, v69, v10
    v_dot2_f32_bf16 v11, v7, v69, v11
    v_dot2_f32_bf16 v12, v6, v70, v12
    v_dot2_f32_bf16 v13, v7, v70, v13
    v_dot2_f32_bf16 v14, v6, v71, v14
    v_dot2_f32_bf16 v15, v7, v71, v15
    v_and_b32 v4, 0xffff, v25
    v_lshlrev_b32 v5, 16, v25
    v_dot2_f32_bf16 v8, v4, v72, v8
    v_dot2_f32_bf16 v9, v5, v72, v9
    v_dot2_f32_bf16 v10, v4, v73, v10
    v_dot2_f32_bf16 v11, v5, v73, v11
    v_dot2_f32_bf16 v12, v4, v74, v12
    v_dot2_f32_bf16 v13, v5, v74, v13
    v_dot2_f32_bf16 v14, v4, v75, v14
    v_dot2_f32_bf16 v15, v5, v75, v15
    v_lshrrev_b32 v6, 16, v25
    v_and_b32 v7, 0xffff0000, v25
    v_dot2_f32_bf16 v8, v6, v76, v8
    v_dot2_f32_bf16 v9, v7, v76, v9
    v_dot2_f32_bf16 v10, v6, v77, v10
    v_dot2_f32_bf16 v11, v7, v77, v11
    v_dot2_f32_bf16 v12, v6, v78, v12
    v_dot2_f32_bf16 v13, v7, v78, v13
    v_dot2_f32_bf16 v14, v6, v79, v14
    v_dot2_f32_bf16 v15, v7, v79, v15
    v_and_b32 v4, 0xffff, v26
    v_lshlrev_b32 v5, 16, v26
    v_dot2_f32_bf16 v8, v4, v80, v8
    v_dot2_f32_bf16 v9, v5, v80, v9
    v_dot2_f32_bf16 v10, v4, v81, v10
    v_dot2_f32_bf16 v11, v5, v81, v11
    v_dot2_f32_bf16 v12, v4, v82, v12
    v_dot2_f32_bf16 v13, v5, v82, v13
    v_dot2_f32_bf16 v14, v4, v83, v14
    v_dot2_f32_bf16 v15, v5, v83, v15
    v_lshrrev_b32 v6, 16, v26
    v_and_b32 v7, 0xffff0000, v26
    v_dot2_f32_bf16 v8, v6, v84, v8
    v_dot2_f32_bf16 v9, v7, v84, v9
    v_dot2_f32_bf16 v10, v6, v85, v10
    v_dot2_f32_bf16 v11, v7, v85, v11
    v_dot2_f32_bf16 v12, v6, v86, v12
    v_dot2_f32_bf16 v13, v7, v86, v13
    v_dot2_f32_bf16 v14, v6, v87, v14
    v_dot2_f32_bf16 v15, v7, v87, v15
    v_and_b32 v4, 0xffff, v27
    v_lshlrev_b32 v5, 16, v27
    v_dot2_f32_bf16 v8, v4, v88, v8
    v_dot2_f32_bf16 v9, v5, v88, v9
    v_dot2_f32_bf16 v10, v4, v89, v10
    v_dot2_f32_bf16 v11, v5, v89, v11
    v_dot2_f32_bf16 v12, v4, v90, v12
    v_dot2_f32_bf16 v13, v5, v90, v13
    v_dot2_f32_bf16 v14, v4, v91, v14
    v_dot2_f32_bf16 v15, v5, v91, v15
    v_lshrrev_b32 v6, 16, v27
    v_and_b32 v7, 0xffff0000, v27
    v_dot2_f32_bf16 v8, v6, v92, v8
    v_dot2_f32_bf16 v9, v7, v92, v9
    v_dot2_f32_bf16 v10, v6, v93, v10
    v_dot2_f32_bf16 v11, v7, v93, v11
    v_dot2_f32_bf16 v12, v6, v94, v12
    v_dot2_f32_bf16 v13, v7, v94, v13
    v_dot2_f32_bf16 v14, v6, v95, v14
    v_dot2_f32_bf16 v15, v7, v95, v15
    v_permlane32_swap_b32 v8, v12
    v_permlane32_swap_b32 v9, v13
    v_permlane32_swap_b32 v10, v14
    v_permlane32_swap_b32 v11, v15
    v_add_f32 v8, v8, v12
    v_add_f32 v9, v9, v13
    v_add_f32 v10, v10, v14
    v_add_f32 v11, v11, v15
    s_nop 0
    v_permlane16_swap_b32 v8, v10
    v_permlane16_swap_b32 v9, v11
    v_add_f32 v8, v8, v10
    v_add_f32 v9, v9, v11
    v_lshrrev_b32 v16, 6, v0
    v_lshlrev_b32 v16, 9, v16
    v_lshl_add_u32 v16, v3, 5, v16
    v_bfe_u32 v17, v0, 4, 2
    v_lshl_add_u32 v16, v17, 3, v16
    ds_write_b64 v16, v[8:9]
    v_mul_u32_u24 v18, 1024, v17
    v_lshl_add_u32 v18, v3, 5, v18
    s_waitcnt lgkmcnt(0)
    s_barrier
    ds_read_b128 v[8:11], v18 offset:0
    ds_read_b128 v[12:15], v18 offset:16
    ds_read_b128 v[20:23], v18 offset:512
    ds_read_b128 v[24:27], v18 offset:528
    s_waitcnt lgkmcnt(0)
    v_add_f32 v8, v8, v20
    v_add_f32 v9, v9, v21
    v_add_f32 v10, v10, v22
    v_add_f32 v11, v11, v23
    v_add_f32 v12, v12, v24
    v_add_f32 v13, v13, v25
    v_add_f32 v14, v14, v26
    v_add_f32 v15, v15, v27
    v_permlane32_swap_b32 v8, v12
    v_permlane32_swap_b32 v9, v13
    v_permlane32_swap_b32 v10, v14
    v_permlane32_swap_b32 v11, v15
    v_add_f32 v8, v8, v12
    v_add_f32 v9, v9, v13
    v_add_f32 v10, v10, v14
    v_add_f32 v11, v11, v15
    s_nop 0
    v_permlane16_swap_b32 v8, v10
    v_permlane16_swap_b32 v9, v11
    v_add_f32 v8, v8, v10
    v_add_f32 v9, v9, v11
    v_cvt_pk_bf16_f32 v8, v8, v9
    v_lshrrev_b32 v18, 6, v0
    v_lshlrev_b32 v18, 8, v18
    v_lshl_add_u32 v18, v3, 4, v18
    v_lshl_add_u32 v19, v17, 2, v18
    ds_write_b32 v19, v8 offset:4096
    s_waitcnt lgkmcnt(0)
    ds_read_b128 v[4:7], v18 offset:4096
    v_mov_b32 v8, 0
    v_mov_b32 v9, 0
    v_mov_b32 v10, 0
    v_mov_b32 v11, 0
    v_mov_b32 v12, 0
    v_mov_b32 v13, 0
    v_mov_b32 v14, 0
    v_mov_b32 v15, 0
    s_waitcnt lgkmcnt(0)
    v_mov_b32 v16, 0xf149f2ca
    v_mov_b32 v17, 0xf149f2ca
    v_mov_b32 v18, 0
    s_add_u32 s55, s50, 65536
    s_mov_b32 s56, 0
L_loop:
    s_waitcnt vmcnt(12)
    v_dot2_f32_bf16 v20, v4, v96, 0
    v_dot2_f32_bf16 v21, v4, v100, 0
    v_dot2_f32_bf16 v22, v4, v104, 0
    v_dot2_f32_bf16 v23, v4, v108, 0
    v_dot2_f32_bf16 v20, v5, v97, v20
    v_dot2_f32_bf16 v21, v5, v101, v21
    v_dot2_f32_bf16 v22, v5, v105, v22
    v_dot2_f32_bf16 v23, v5, v109, v23
    v_dot2_f32_bf16 v20, v6, v98, v20
    v_dot2_f32_bf16 v21, v6, v102, v21
    v_dot2_f32_bf16 v22, v6, v106, v22
    v_dot2_f32_bf16 v23, v6, v110, v23
    v_dot2_f32_bf16 v20, v7, v99, v20
    v_dot2_f32_bf16 v21, v7, v103, v21
    v_dot2_f32_bf16 v22, v7, v107, v22
    v_dot2_f32_bf16 v23, v7, v111, v23
    buffer_load_dwordx4 v[96:99], v1, s[28:31], s55 offen offset:0 nt
    buffer_load_dwordx4 v[100:103], v1, s[28:31], s55 offen offset:1024 nt
    buffer_load_dwordx4 v[104:107], v1, s[28:31], s55 offen offset:2048 nt
    buffer_load_dwordx4 v[108:111], v1, s[28:31], s55 offen offset:3072 nt
    v_add_f32_dpp v20, v20, v20 row_ror:8 row_mask:0xf bank_mask:0xf
    v_add_f32_dpp v21, v21, v21 row_ror:8 row_mask:0xf bank_mask:0xf
    v_add_f32_dpp v22, v22, v22 row_ror:8 row_mask:0xf bank_mask:0xf
    v_add_f32_dpp v23, v23, v23 row_ror:8 row_mask:0xf bank_mask:0xf
    v_add_f32_dpp v20, v20, v20 row_ror:4 row_mask:0xf bank_mask:0xf
    v_add_f32_dpp v21, v21, v21 row_ror:4 row_mask:0xf bank_mask:0xf
    v_add_f32_dpp v22, v22, v22 row_ror:4 row_mask:0xf bank_mask:0xf
    v_add_f32_dpp v23, v23, v23 row_ror:4 row_mask:0xf bank_mask:0xf
    v_add_f32_dpp v20, v20, v20 row_ror:2 row_mask:0xf bank_mask:0xf
    v_add_f32_dpp v21, v21, v21 row_ror:2 row_mask:0xf bank_mask:0xf
    v_add_f32_dpp v22, v22, v22 row_ror:2 row_mask:0xf bank_mask:0xf
    v_add_f32_dpp v23, v23, v23 row_ror:2 row_mask:0xf bank_mask:0xf
    v_add_f32_dpp v20, v20, v20 row_ror:1 row_mask:0xf bank_mask:0xf
    v_add_f32_dpp v21, v21, v21 row_ror:1 row_mask:0xf bank_mask:0xf
    v_add_f32_dpp v22, v22, v22 row_ror:1 row_mask:0xf bank_mask:0xf
    v_add_f32_dpp v23, v23, v23 row_ror:1 row_mask:0xf bank_mask:0xf
    v_max3_f32 v16, v20, v21, v16
    v_max3_f32 v16, v22, v23, v16
    v_mul_f32 v24, s70, v16
    v_sub_f32 v19, v17, v24
    v_mov_b32 v17, v24
    v_exp_f32 v19, v19
    v_fma_f32 v20, v20, s70, -v17
    v_fma_f32 v21, v21, s70, -v17
    v_fma_f32 v22, v22, s70, -v17
    v_fma_f32 v23, v23, s70, -v17
    v_exp_f32 v20, v20
    v_exp_f32 v21, v21
    v_exp_f32 v22, v22
    v_exp_f32 v23, v23
    v_fma_f32 v18, v18, v19, v20
    v_mul_f32 v8, v19, v8
    v_mul_f32 v9, v19, v9
    v_mul_f32 v10, v19, v10
    v_mul_f32 v11, v19, v11
    v_mul_f32 v12, v19, v12
    v_mul_f32 v13, v19, v13
    v_mul_f32 v14, v19, v14
    v_mul_f32 v15, v19, v15
    v_cvt_pk_bf16_f32 v24, v20, 0
    v_cvt_pk_bf16_f32 v28, 0, v20
    v_cvt_pk_bf16_f32 v25, v21, 0
    v_cvt_pk_bf16_f32 v29, 0, v21
    v_cvt_pk_bf16_f32 v26, v22, 0
    v_cvt_pk_bf16_f32 v30, 0, v22
    v_cvt_pk_bf16_f32 v27, v23, 0
    v_cvt_pk_bf16_f32 v31, 0, v23
    v_add_f32 v18, v18, v21
    v_add_f32 v18, v18, v22
    v_add_f32 v18, v18, v23
    s_waitcnt vmcnt(12)
    v_dot2_f32_bf16 v8, v24, v112, v8
    v_dot2_f32_bf16 v9, v28, v112, v9
    v_dot2_f32_bf16 v10, v24, v113, v10
    v_dot2_f32_bf16 v11, v28, v113, v11
    v_dot2_f32_bf16 v12, v24, v114, v12
    v_dot2_f32_bf16 v13, v28, v114, v13
    v_dot2_f32_bf16 v14, v24, v115, v14
    v_dot2_f32_bf16 v15, v28, v115, v15
    v_dot2_f32_bf16 v8, v25, v116, v8
    v_dot2_f32_bf16 v9, v29, v116, v9
    v_dot2_f32_bf16 v10, v25, v117, v10
    v_dot2_f32_bf16 v11, v29, v117, v11
    v_dot2_f32_bf16 v12, v25, v118, v12
    v_dot2_f32_bf16 v13, v29, v118, v13
    v_dot2_f32_bf16 v14, v25, v119, v14
    v_dot2_f32_bf16 v15, v29, v119, v15
    v_dot2_f32_bf16 v8, v26, v120, v8
    v_dot2_f32_bf16 v9, v30, v120, v9
    v_dot2_f32_bf16 v10, v26, v121, v10
    v_dot2_f32_bf16 v11, v30, v121, v11
    v_dot2_f32_bf16 v12, v26, v122, v12
    v_dot2_f32_bf16 v13, v30, v122, v13
    v_dot2_f32_bf16 v14, v26, v123, v14
    v_dot2_f32_bf16 v15, v30, v123, v15
    v_dot2_f32_bf16 v8, v27, v124, v8
    v_dot2_f32_bf16 v9, v31, v124, v9
    v_dot2_f32_bf16 v10, v27, v125, v10
    v_dot2_f32_bf16 v11, v31, v125, v11
    v_dot2_f32_bf16 v12, v27, v126, v12
    v_dot2_f32_bf16 v13, v31, v126, v13
    v_dot2_f32_bf16 v14, v27, v127, v14
    v_dot2_f32_bf16 v15, v31, v127, v15
    buffer_load_dwordx4 v[112:115], v1, s[32:35], s55 offen offset:0 nt
    buffer_load_dwordx4 v[116:119], v1, s[32:35], s55 offen offset:1024 nt
    buffer_load_dwordx4 v[120:123], v1, s[32:35], s55 offen offset:2048 nt
    buffer_load_dwordx4 v[124:127], v1, s[32:35], s55 offen offset:3072 nt
    s_add_u32 s55, s55, 32768
    s_waitcnt vmcnt(12)
    v_dot2_f32_bf16 v20, v4, v128, 0
    v_dot2_f32_bf16 v21, v4, v132, 0
    v_dot2_f32_bf16 v22, v4, v136, 0
    v_dot2_f32_bf16 v23, v4, v140, 0
    v_dot2_f32_bf16 v20, v5, v129, v20
    v_dot2_f32_bf16 v21, v5, v133, v21
    v_dot2_f32_bf16 v22, v5, v137, v22
    v_dot2_f32_bf16 v23, v5, v141, v23
    v_dot2_f32_bf16 v20, v6, v130, v20
    v_dot2_f32_bf16 v21, v6, v134, v21
    v_dot2_f32_bf16 v22, v6, v138, v22
    v_dot2_f32_bf16 v23, v6, v142, v23
    v_dot2_f32_bf16 v20, v7, v131, v20
    v_dot2_f32_bf16 v21, v7, v135, v21
    v_dot2_f32_bf16 v22, v7, v139, v22
    v_dot2_f32_bf16 v23, v7, v143, v23
    buffer_load_dwordx4 v[128:131], v1, s[28:31], s55 offen offset:0 nt
    buffer_load_dwordx4 v[132:135], v1, s[28:31], s55 offen offset:1024 nt
    buffer_load_dwordx4 v[136:139], v1, s[28:31], s55 offen offset:2048 nt
    buffer_load_dwordx4 v[140:143], v1, s[28:31], s55 offen offset:3072 nt
    v_add_f32_dpp v20, v20, v20 row_ror:8 row_mask:0xf bank_mask:0xf
    v_add_f32_dpp v21, v21, v21 row_ror:8 row_mask:0xf bank_mask:0xf
    v_add_f32_dpp v22, v22, v22 row_ror:8 row_mask:0xf bank_mask:0xf
    v_add_f32_dpp v23, v23, v23 row_ror:8 row_mask:0xf bank_mask:0xf
    v_add_f32_dpp v20, v20, v20 row_ror:4 row_mask:0xf bank_mask:0xf
    v_add_f32_dpp v21, v21, v21 row_ror:4 row_mask:0xf bank_mask:0xf
    v_add_f32_dpp v22, v22, v22 row_ror:4 row_mask:0xf bank_mask:0xf
    v_add_f32_dpp v23, v23, v23 row_ror:4 row_mask:0xf bank_mask:0xf
    v_add_f32_dpp v20, v20, v20 row_ror:2 row_mask:0xf bank_mask:0xf
    v_add_f32_dpp v21, v21, v21 row_ror:2 row_mask:0xf bank_mask:0xf
    v_add_f32_dpp v22, v22, v22 row_ror:2 row_mask:0xf bank_mask:0xf
    v_add_f32_dpp v23, v23, v23 row_ror:2 row_mask:0xf bank_mask:0xf
    v_add_f32_dpp v20, v20, v20 row_ror:1 row_mask:0xf bank_mask:0xf
    v_add_f32_dpp v21, v21, v21 row_ror:1 row_mask:0xf bank_mask:0xf
    v_add_f32_dpp v22, v22, v22 row_ror:1 row_mask:0xf bank_mask:0xf
    v_add_f32_dpp v23, v23, v23 row_ror:1 row_mask:0xf bank_mask:0xf
    v_max3_f32 v16, v20, v21, v16
    v_max3_f32 v16, v22, v23, v16
    v_mul_f32 v24, s70, v16
    v_sub_f32 v19, v17, v24
    v_mov_b32 v17, v24
    v_exp_f32 v19, v19
    v_fma_f32 v20, v20, s70, -v17
    v_fma_f32 v21, v21, s70, -v17
    v_fma_f32 v22, v22, s70, -v17
    v_fma_f32 v23, v23, s70, -v17
    v_exp_f32 v20, v20
    v_exp_f32 v21, v21
    v_exp_f32 v22, v22
    v_exp_f32 v23, v23
    v_fma_f32 v18, v18, v19, v20
    v_mul_f32 v8, v19, v8
    v_mul_f32 v9, v19, v9
    v_mul_f32 v10, v19, v10
    v_mul_f32 v11, v19, v11
    v_mul_f32 v12, v19, v12
    v_mul_f32 v13, v19, v13
    v_mul_f32 v14, v19, v14
    v_mul_f32 v15, v19, v15
    v_cvt_pk_bf16_f32 v24, v20, 0
    v_cvt_pk_bf16_f32 v28, 0, v20
    v_cvt_pk_bf16_f32 v25, v21, 0
    v_cvt_pk_bf16_f32 v29, 0, v21
    v_cvt_pk_bf16_f32 v26, v22, 0
    v_cvt_pk_bf16_f32 v30, 0, v22
    v_cvt_pk_bf16_f32 v27, v23, 0
    v_cvt_pk_bf16_f32 v31, 0, v23
    v_add_f32 v18, v18, v21
    v_add_f32 v18, v18, v22
    v_add_f32 v18, v18, v23
    s_waitcnt vmcnt(12)
    v_dot2_f32_bf16 v8, v24, v144, v8
    v_dot2_f32_bf16 v9, v28, v144, v9
    v_dot2_f32_bf16 v10, v24, v145, v10
    v_dot2_f32_bf16 v11, v28, v145, v11
    v_dot2_f32_bf16 v12, v24, v146, v12
    v_dot2_f32_bf16 v13, v28, v146, v13
    v_dot2_f32_bf16 v14, v24, v147, v14
    v_dot2_f32_bf16 v15, v28, v147, v15
    v_dot2_f32_bf16 v8, v25, v148, v8
    v_dot2_f32_bf16 v9, v29, v148, v9
    v_dot2_f32_bf16 v10, v25, v149, v10
    v_dot2_f32_bf16 v11, v29, v149, v11
    v_dot2_f32_bf16 v12, v25, v150, v12
    v_dot2_f32_bf16 v13, v29, v150, v13
    v_dot2_f32_bf16 v14, v25, v151, v14
    v_dot2_f32_bf16 v15, v29, v151, v15
    v_dot2_f32_bf16 v8, v26, v152, v8
    v_dot2_f32_bf16 v9, v30, v152, v9
    v_dot2_f32_bf16 v10, v26, v153, v10
    v_dot2_f32_bf16 v11, v30, v153, v11
    v_dot2_f32_bf16 v12, v26, v154, v12
    v_dot2_f32_bf16 v13, v30, v154, v13
    v_dot2_f32_bf16 v14, v26, v155, v14
    v_dot2_f32_bf16 v15, v30, v155, v15
    v_dot2_f32_bf16 v8, v27, v156, v8
    v_dot2_f32_bf16 v9, v31, v156, v9
    v_dot2_f32_bf16 v10, v27, v157, v10
    v_dot2_f32_bf16 v11, v31, v157, v11
    v_dot2_f32_bf16 v12, v27, v158, v12
    v_dot2_f32_bf16 v13, v31, v158, v13
    v_dot2_f32_bf16 v14, v27, v159, v14
    v_dot2_f32_bf16 v15, v31, v159, v15
    buffer_load_dwordx4 v[144:147], v1, s[32:35], s55 offen offset:0 nt
    buffer_load_dwordx4 v[148:151], v1, s[32:35], s55 offen offset:1024 nt
    buffer_load_dwordx4 v[152:155], v1, s[32:35], s55 offen offset:2048 nt
    buffer_load_dwordx4 v[156:159], v1, s[32:35], s55 offen offset:3072 nt
    s_add_u32 s55, s55, 32768
    s_cmp_lg_u32 s56, 2
    s_cbranch_scc1 L_nowo
    buffer_load_dwordx4 v[32:35], v2, s[40:43], s68 offen offset:0
    buffer_load_dwordx4 v[36:39], v2, s[40:43], s68 offen offset:1024
    buffer_load_dwordx4 v[40:43], v2, s[40:43], s68 offen offset:2048
    buffer_load_dwordx4 v[44:47], v2, s[40:43], s68 offen offset:3072
    s_add_u32 s68, s68, 4096
    buffer_load_dwordx4 v[48:51], v2, s[40:43], s68 offen offset:0
    buffer_load_dwordx4 v[52:55], v2, s[40:43], s68 offen offset:1024
    buffer_load_dwordx4 v[56:59], v2, s[40:43], s68 offen offset:2048
    buffer_load_dwordx4 v[60:63], v2, s[40:43], s68 offen offset:3072
    s_add_u32 s68, s68, 4096
    buffer_load_dwordx4 v[64:67], v2, s[40:43], s68 offen offset:0
    buffer_load_dwordx4 v[68:71], v2, s[40:43], s68 offen offset:1024
    buffer_load_dwordx4 v[72:75], v2, s[40:43], s68 offen offset:2048
    buffer_load_dwordx4 v[76:79], v2, s[40:43], s68 offen offset:3072
    s_add_u32 s68, s68, 4096
    buffer_load_dwordx4 v[80:83], v2, s[40:43], s68 offen offset:0
    buffer_load_dwordx4 v[84:87], v2, s[40:43], s68 offen offset:1024
    buffer_load_dwordx4 v[88:91], v2, s[40:43], s68 offen offset:2048
    buffer_load_dwordx4 v[92:95], v2, s[40:43], s68 offen offset:3072
L_nowo:
    s_cmp_lg_u32 s56, 5
    s_cbranch_scc1 L_noperm
    s_waitcnt vmcnt(16)
    v_perm_b32 v2, v36, v32, s74
    v_perm_b32 v36, v36, v32, s75
    v_perm_b32 v32, v37, v33, s74
    v_perm_b32 v37, v37, v33, s75
    v_perm_b32 v33, v38, v34, s74
    v_perm_b32 v38, v38, v34, s75
    v_perm_b32 v34, v39, v35, s74
    v_perm_b32 v39, v39, v35, s75
    v_perm_b32 v35, v44, v40, s74
    v_perm_b32 v44, v44, v40, s75
    v_perm_b32 v40, v45, v41, s74
    v_perm_b32 v45, v45, v41, s75
    v_perm_b32 v41, v46, v42, s74
    v_perm_b32 v46, v46, v42, s75
    v_perm_b32 v42, v47, v43, s74
    v_perm_b32 v47, v47, v43, s75
    v_perm_b32 v43, v52, v48, s74
    v_perm_b32 v52, v52, v48, s75
    v_perm_b32 v48, v53, v49, s74
    v_perm_b32 v53, v53, v49, s75
    v_perm_b32 v49, v54, v50, s74
    v_perm_b32 v54, v54, v50, s75
    v_perm_b32 v50, v55, v51, s74
    v_perm_b32 v55, v55, v51, s75
    v_perm_b32 v51, v60, v56, s74
    v_perm_b32 v60, v60, v56, s75
    v_perm_b32 v56, v61, v57, s74
    v_perm_b32 v61, v61, v57, s75
    v_perm_b32 v57, v62, v58, s74
    v_perm_b32 v62, v62, v58, s75
    v_perm_b32 v58, v63, v59, s74
    v_perm_b32 v63, v63, v59, s75
    v_perm_b32 v59, v68, v64, s74
    v_perm_b32 v68, v68, v64, s75
    v_perm_b32 v64, v69, v65, s74
    v_perm_b32 v69, v69, v65, s75
    v_perm_b32 v65, v70, v66, s74
    v_perm_b32 v70, v70, v66, s75
    v_perm_b32 v66, v71, v67, s74
    v_perm_b32 v71, v71, v67, s75
    v_perm_b32 v67, v76, v72, s74
    v_perm_b32 v76, v76, v72, s75
    v_perm_b32 v72, v77, v73, s74
    v_perm_b32 v77, v77, v73, s75
    v_perm_b32 v73, v78, v74, s74
    v_perm_b32 v78, v78, v74, s75
    v_perm_b32 v74, v79, v75, s74
    v_perm_b32 v79, v79, v75, s75
    v_perm_b32 v75, v84, v80, s74
    v_perm_b32 v84, v84, v80, s75
    v_perm_b32 v80, v85, v81, s74
    v_perm_b32 v85, v85, v81, s75
    v_perm_b32 v81, v86, v82, s74
    v_perm_b32 v86, v86, v82, s75
    v_perm_b32 v82, v87, v83, s74
    v_perm_b32 v87, v87, v83, s75
    v_perm_b32 v83, v92, v88, s74
    v_perm_b32 v92, v92, v88, s75
    v_perm_b32 v88, v93, v89, s74
    v_perm_b32 v93, v93, v89, s75
    v_perm_b32 v89, v94, v90, s74
    v_perm_b32 v94, v94, v90, s75
    v_perm_b32 v90, v95, v91, s74
    v_perm_b32 v95, v95, v91, s75
L_noperm:
    s_add_u32 s56, s56, 1
    s_cmp_lt_u32 s56, 7
    s_cbranch_scc1 L_loop
    s_waitcnt vmcnt(12)
    v_dot2_f32_bf16 v20, v4, v96, 0
    v_dot2_f32_bf16 v21, v4, v100, 0
    v_dot2_f32_bf16 v22, v4, v104, 0
    v_dot2_f32_bf16 v23, v4, v108, 0
    v_dot2_f32_bf16 v20, v5, v97, v20
    v_dot2_f32_bf16 v21, v5, v101, v21
    v_dot2_f32_bf16 v22, v5, v105, v22
    v_dot2_f32_bf16 v23, v5, v109, v23
    v_dot2_f32_bf16 v20, v6, v98, v20
    v_dot2_f32_bf16 v21, v6, v102, v21
    v_dot2_f32_bf16 v22, v6, v106, v22
    v_dot2_f32_bf16 v23, v6, v110, v23
    v_dot2_f32_bf16 v20, v7, v99, v20
    v_dot2_f32_bf16 v21, v7, v103, v21
    v_dot2_f32_bf16 v22, v7, v107, v22
    v_dot2_f32_bf16 v23, v7, v111, v23
    v_add_f32_dpp v20, v20, v20 row_ror:8 row_mask:0xf bank_mask:0xf
    v_add_f32_dpp v21, v21, v21 row_ror:8 row_mask:0xf bank_mask:0xf
    v_add_f32_dpp v22, v22, v22 row_ror:8 row_mask:0xf bank_mask:0xf
    v_add_f32_dpp v23, v23, v23 row_ror:8 row_mask:0xf bank_mask:0xf
    v_add_f32_dpp v20, v20, v20 row_ror:4 row_mask:0xf bank_mask:0xf
    v_add_f32_dpp v21, v21, v21 row_ror:4 row_mask:0xf bank_mask:0xf
    v_add_f32_dpp v22, v22, v22 row_ror:4 row_mask:0xf bank_mask:0xf
    v_add_f32_dpp v23, v23, v23 row_ror:4 row_mask:0xf bank_mask:0xf
    v_add_f32_dpp v20, v20, v20 row_ror:2 row_mask:0xf bank_mask:0xf
    v_add_f32_dpp v21, v21, v21 row_ror:2 row_mask:0xf bank_mask:0xf
    v_add_f32_dpp v22, v22, v22 row_ror:2 row_mask:0xf bank_mask:0xf
    v_add_f32_dpp v23, v23, v23 row_ror:2 row_mask:0xf bank_mask:0xf
    v_add_f32_dpp v20, v20, v20 row_ror:1 row_mask:0xf bank_mask:0xf
    v_add_f32_dpp v21, v21, v21 row_ror:1 row_mask:0xf bank_mask:0xf
    v_add_f32_dpp v22, v22, v22 row_ror:1 row_mask:0xf bank_mask:0xf
    v_add_f32_dpp v23, v23, v23 row_ror:1 row_mask:0xf bank_mask:0xf
    v_max3_f32 v16, v20, v21, v16
    v_max3_f32 v16, v22, v23, v16
    v_mul_f32 v24, s70, v16
    v_sub_f32 v19, v17, v24
    v_mov_b32 v17, v24
    v_exp_f32 v19, v19
    v_fma_f32 v20, v20, s70, -v17
    v_fma_f32 v21, v21, s70, -v17
    v_fma_f32 v22, v22, s70, -v17
    v_fma_f32 v23, v23, s70, -v17
    v_exp_f32 v20, v20
    v_exp_f32 v21, v21
    v_exp_f32 v22, v22
    v_exp_f32 v23, v23
    v_fma_f32 v18, v18, v19, v20
    v_mul_f32 v8, v19, v8
    v_mul_f32 v9, v19, v9
    v_mul_f32 v10, v19, v10
    v_mul_f32 v11, v19, v11
    v_mul_f32 v12, v19, v12
    v_mul_f32 v13, v19, v13
    v_mul_f32 v14, v19, v14
    v_mul_f32 v15, v19, v15
    v_cvt_pk_bf16_f32 v24, v20, 0
    v_cvt_pk_bf16_f32 v28, 0, v20
    v_cvt_pk_bf16_f32 v25, v21, 0
    v_cvt_pk_bf16_f32 v29, 0, v21
    v_cvt_pk_bf16_f32 v26, v22, 0
    v_cvt_pk_bf16_f32 v30, 0, v22
    v_cvt_pk_bf16_f32 v27, v23, 0
    v_cvt_pk_bf16_f32 v31, 0, v23
    v_add_f32 v18, v18, v21
    v_add_f32 v18, v18, v22
    v_add_f32 v18, v18, v23
    s_waitcnt vmcnt(8)
    v_dot2_f32_bf16 v8, v24, v112, v8
    v_dot2_f32_bf16 v9, v28, v112, v9
    v_dot2_f32_bf16 v10, v24, v113, v10
    v_dot2_f32_bf16 v11, v28, v113, v11
    v_dot2_f32_bf16 v12, v24, v114, v12
    v_dot2_f32_bf16 v13, v28, v114, v13
    v_dot2_f32_bf16 v14, v24, v115, v14
    v_dot2_f32_bf16 v15, v28, v115, v15
    v_dot2_f32_bf16 v8, v25, v116, v8
    v_dot2_f32_bf16 v9, v29, v116, v9
    v_dot2_f32_bf16 v10, v25, v117, v10
    v_dot2_f32_bf16 v11, v29, v117, v11
    v_dot2_f32_bf16 v12, v25, v118, v12
    v_dot2_f32_bf16 v13, v29, v118, v13
    v_dot2_f32_bf16 v14, v25, v119, v14
    v_dot2_f32_bf16 v15, v29, v119, v15
    v_dot2_f32_bf16 v8, v26, v120, v8
    v_dot2_f32_bf16 v9, v30, v120, v9
    v_dot2_f32_bf16 v10, v26, v121, v10
    v_dot2_f32_bf16 v11, v30, v121, v11
    v_dot2_f32_bf16 v12, v26, v122, v12
    v_dot2_f32_bf16 v13, v30, v122, v13
    v_dot2_f32_bf16 v14, v26, v123, v14
    v_dot2_f32_bf16 v15, v30, v123, v15
    v_dot2_f32_bf16 v8, v27, v124, v8
    v_dot2_f32_bf16 v9, v31, v124, v9
    v_dot2_f32_bf16 v10, v27, v125, v10
    v_dot2_f32_bf16 v11, v31, v125, v11
    v_dot2_f32_bf16 v12, v27, v126, v12
    v_dot2_f32_bf16 v13, v31, v126, v13
    v_dot2_f32_bf16 v14, v27, v127, v14
    v_dot2_f32_bf16 v15, v31, v127, v15
    s_waitcnt vmcnt(4)
    v_dot2_f32_bf16 v20, v4, v128, 0
    v_dot2_f32_bf16 v21, v4, v132, 0
    v_dot2_f32_bf16 v22, v4, v136, 0
    v_dot2_f32_bf16 v23, v4, v140, 0
    v_dot2_f32_bf16 v20, v5, v129, v20
    v_dot2_f32_bf16 v21, v5, v133, v21
    v_dot2_f32_bf16 v22, v5, v137, v22
    v_dot2_f32_bf16 v23, v5, v141, v23
    v_dot2_f32_bf16 v20, v6, v130, v20
    v_dot2_f32_bf16 v21, v6, v134, v21
    v_dot2_f32_bf16 v22, v6, v138, v22
    v_dot2_f32_bf16 v23, v6, v142, v23
    v_dot2_f32_bf16 v20, v7, v131, v20
    v_dot2_f32_bf16 v21, v7, v135, v21
    v_dot2_f32_bf16 v22, v7, v139, v22
    v_dot2_f32_bf16 v23, v7, v143, v23
    v_add_f32_dpp v20, v20, v20 row_ror:8 row_mask:0xf bank_mask:0xf
    v_add_f32_dpp v21, v21, v21 row_ror:8 row_mask:0xf bank_mask:0xf
    v_add_f32_dpp v22, v22, v22 row_ror:8 row_mask:0xf bank_mask:0xf
    v_add_f32_dpp v23, v23, v23 row_ror:8 row_mask:0xf bank_mask:0xf
    v_add_f32_dpp v20, v20, v20 row_ror:4 row_mask:0xf bank_mask:0xf
    v_add_f32_dpp v21, v21, v21 row_ror:4 row_mask:0xf bank_mask:0xf
    v_add_f32_dpp v22, v22, v22 row_ror:4 row_mask:0xf bank_mask:0xf
    v_add_f32_dpp v23, v23, v23 row_ror:4 row_mask:0xf bank_mask:0xf
    v_add_f32_dpp v20, v20, v20 row_ror:2 row_mask:0xf bank_mask:0xf
    v_add_f32_dpp v21, v21, v21 row_ror:2 row_mask:0xf bank_mask:0xf
    v_add_f32_dpp v22, v22, v22 row_ror:2 row_mask:0xf bank_mask:0xf
    v_add_f32_dpp v23, v23, v23 row_ror:2 row_mask:0xf bank_mask:0xf
    v_add_f32_dpp v20, v20, v20 row_ror:1 row_mask:0xf bank_mask:0xf
    v_add_f32_dpp v21, v21, v21 row_ror:1 row_mask:0xf bank_mask:0xf
    v_add_f32_dpp v22, v22, v22 row_ror:1 row_mask:0xf bank_mask:0xf
    v_add_f32_dpp v23, v23, v23 row_ror:1 row_mask:0xf bank_mask:0xf
    v_max3_f32 v16, v20, v21, v16
    v_max3_f32 v16, v22, v23, v16
    v_mul_f32 v24, s70, v16
    v_sub_f32 v19, v17, v24
    v_mov_b32 v17, v24
    v_exp_f32 v19, v19
    v_fma_f32 v20, v20, s70, -v17
    v_fma_f32 v21, v21, s70, -v17
    v_fma_f32 v22, v22, s70, -v17
    v_fma_f32 v23, v23, s70, -v17
    v_exp_f32 v20, v20
    v_exp_f32 v21, v21
    v_exp_f32 v22, v22
    v_exp_f32 v23, v23
    v_fma_f32 v18, v18, v19, v20
    v_mul_f32 v8, v19, v8
    v_mul_f32 v9, v19, v9
    v_mul_f32 v10, v19, v10
    v_mul_f32 v11, v19, v11
    v_mul_f32 v12, v19, v12
    v_mul_f32 v13, v19, v13
    v_mul_f32 v14, v19, v14
    v_mul_f32 v15, v19, v15
    v_cvt_pk_bf16_f32 v24, v20, 0
    v_cvt_pk_bf16_f32 v28, 0, v20
    v_cvt_pk_bf16_f32 v25, v21, 0
    v_cvt_pk_bf16_f32 v29, 0, v21
    v_cvt_pk_bf16_f32 v26, v22, 0
    v_cvt_pk_bf16_f32 v30, 0, v22
    v_cvt_pk_bf16_f32 v27, v23, 0
    v_cvt_pk_bf16_f32 v31, 0, v23
    v_add_f32 v18, v18, v21
    v_add_f32 v18, v18, v22
    v_add_f32 v18, v18, v23
    s_waitcnt vmcnt(0)
    v_dot2_f32_bf16 v8, v24, v144, v8
    v_dot2_f32_bf16 v9, v28, v144, v9
    v_dot2_f32_bf16 v10, v24, v145, v10
    v_dot2_f32_bf16 v11, v28, v145, v11
    v_dot2_f32_bf16 v12, v24, v146, v12
    v_dot2_f32_bf16 v13, v28, v146, v13
    v_dot2_f32_bf16 v14, v24, v147, v14
    v_dot2_f32_bf16 v15, v28, v147, v15
    v_dot2_f32_bf16 v8, v25, v148, v8
    v_dot2_f32_bf16 v9, v29, v148, v9
    v_dot2_f32_bf16 v10, v25, v149, v10
    v_dot2_f32_bf16 v11, v29, v149, v11
    v_dot2_f32_bf16 v12, v25, v150, v12
    v_dot2_f32_bf16 v13, v29, v150, v13
    v_dot2_f32_bf16 v14, v25, v151, v14
    v_dot2_f32_bf16 v15, v29, v151, v15
    v_dot2_f32_bf16 v8, v26, v152, v8
    v_dot2_f32_bf16 v9, v30, v152, v9
    v_dot2_f32_bf16 v10, v26, v153, v10
    v_dot2_f32_bf16 v11, v30, v153, v11
    v_dot2_f32_bf16 v12, v26, v154, v12
    v_dot2_f32_bf16 v13, v30, v154, v13
    v_dot2_f32_bf16 v14, v26, v155, v14
    v_dot2_f32_bf16 v15, v30, v155, v15
    v_dot2_f32_bf16 v8, v27, v156, v8
    v_dot2_f32_bf16 v9, v31, v156, v9
    v_dot2_f32_bf16 v10, v27, v157, v10
    v_dot2_f32_bf16 v11, v31, v157, v11
    v_dot2_f32_bf16 v12, v27, v158, v12
    v_dot2_f32_bf16 v13, v31, v158, v13
    v_dot2_f32_bf16 v14, v27, v159, v14
    v_dot2_f32_bf16 v15, v31, v159, v15
    v_mov_b32 v22, v17
    v_mov_b32 v23, v22
    s_nop 1
    v_permlane32_swap_b32 v22, v23
    v_max_f32 v22, v22, v23
    v_mov_b32 v23, v22
    s_nop 1
    v_permlane16_swap_b32 v22, v23
    v_max_f32 v22, v22, v23
    v_sub_f32 v19, v17, v22
    v_exp_f32 v19, v19
    v_lshrrev_b32 v25, 6, v0
    v_lshlrev_b32 v26, 9, v25
    v_mul_f32 v8, v19, v8
    v_mul_f32 v9, v19, v9
    v_mul_f32 v10, v19, v10
    v_mul_f32 v11, v19, v11
    v_mul_f32 v12, v19, v12
    v_mul_f32 v13, v19, v13
    v_mul_f32 v14, v19, v14
    v_mul_f32 v15, v19, v15
    v_mul_f32 v23, v19, v18
    v_permlane32_swap_b32 v8, v12
    v_permlane32_swap_b32 v9, v13
    v_permlane32_swap_b32 v10, v14
    v_permlane32_swap_b32 v11, v15
    v_add_f32 v8, v8, v12
    v_add_f32 v9, v9, v13
    v_add_f32 v10, v10, v14
    v_add_f32 v11, v11, v15
    s_nop 0
    v_permlane16_swap_b32 v8, v10
    v_permlane16_swap_b32 v9, v11
    v_add_f32 v8, v8, v10
    v_add_f32 v9, v9, v11
    v_mov_b32 v24, v23
    s_nop 1
    v_permlane32_swap_b32 v23, v24
    v_add_f32 v23, v23, v24
    v_mov_b32 v24, v23
    s_nop 1
    v_permlane16_swap_b32 v23, v24
    v_add_f32 v23, v23, v24
    v_lshl_add_u32 v26, v3, 5, v26
    v_bfe_u32 v27, v0, 4, 2
    v_lshl_add_u32 v26, v27, 3, v26
    ds_write_b64 v26, v[8:9] offset:6144
    v_lshlrev_b32 v26, 3, v25
    ds_write_b64 v26, v[22:23] offset:10240
    v_and_b32 v28, 63, v0
    v_lshrrev_b32 v29, 4, v28
    v_and_b32 v28, 15, v28
    v_lshlrev_b32 v26, 4, v29
    v_lshlrev_b32 v27, 10, v29
    v_lshl_add_u32 v27, v25, 6, v27
    v_lshl_add_u32 v27, v28, 2, v27
    s_waitcnt lgkmcnt(0)
    s_barrier
    ds_read_b128 v[20:23], v26 offset:10240
    ds_read_b32 v8, v27 offset:6144
    ds_read_b32 v9, v27 offset:6656
    s_waitcnt lgkmcnt(0)
    v_max_f32 v16, v20, v22
    v_mov_b32 v24, v16
    s_nop 1
    v_permlane32_swap_b32 v16, v24
    v_max_f32 v16, v16, v24
    v_mov_b32 v24, v16
    s_nop 1
    v_permlane16_swap_b32 v16, v24
    v_max_f32 v16, v16, v24
    v_sub_f32 v20, v20, v16
    v_sub_f32 v22, v22, v16
    v_exp_f32 v20, v20
    v_exp_f32 v22, v22
    v_mul_f32 v8, v20, v8
    v_mul_f32 v17, v20, v21
    v_fma_f32 v8, v22, v9, v8
    v_fma_f32 v17, v22, v23, v17
    v_mov_b32 v24, v8
    s_nop 1
    v_permlane32_swap_b32 v8, v24
    v_add_f32 v8, v8, v24
    v_mov_b32 v24, v8
    s_nop 1
    v_permlane16_swap_b32 v8, v24
    v_add_f32 v8, v8, v24
    s_nop 1
    v_mov_b32_dpp v9, v8 quad_perm:[1,0,3,2] row_mask:0xf bank_mask:0xf
    v_cvt_pk_bf16_f32 v8, v8, v9
    s_nop 0
    v_readlane_b32 s24, v8, 0
    v_readlane_b32 s25, v8, 2
    v_readlane_b32 s26, v8, 4
    v_readlane_b32 s27, v8, 6
    v_readlane_b32 s28, v8, 8
    v_readlane_b32 s29, v8, 10
    v_readlane_b32 s30, v8, 12
    v_readlane_b32 s31, v8, 14
    v_mov_b32 v24, v17
    s_nop 1
    v_permlane32_swap_b32 v17, v24
    v_add_f32 v17, v17, v24
    v_mov_b32 v24, v17
    s_nop 1
    v_permlane16_swap_b32 v17, v24
    v_add_f32 v17, v17, v24
    v_dot2_f32_bf16 v8, s24, v2, 0
    v_dot2_f32_bf16 v9, s24, v36, 0
    v_dot2_f32_bf16 v10, s24, v32, 0
    v_dot2_f32_bf16 v11, s24, v37, 0
    v_dot2_f32_bf16 v12, s24, v33, 0
    v_dot2_f32_bf16 v13, s24, v38, 0
    v_dot2_f32_bf16 v14, s24, v34, 0
    v_dot2_f32_bf16 v15, s24, v39, 0
    v_dot2_f32_bf16 v8, s25, v35, v8
    v_dot2_f32_bf16 v9, s25, v44, v9
    v_dot2_f32_bf16 v10, s25, v40, v10
    v_dot2_f32_bf16 v11, s25, v45, v11
    v_dot2_f32_bf16 v12, s25, v41, v12
    v_dot2_f32_bf16 v13, s25, v46, v13
    v_dot2_f32_bf16 v14, s25, v42, v14
    v_dot2_f32_bf16 v15, s25, v47, v15
    v_dot2_f32_bf16 v8, s26, v43, v8
    v_dot2_f32_bf16 v9, s26, v52, v9
    v_dot2_f32_bf16 v10, s26, v48, v10
    v_dot2_f32_bf16 v11, s26, v53, v11
    v_dot2_f32_bf16 v12, s26, v49, v12
    v_dot2_f32_bf16 v13, s26, v54, v13
    v_dot2_f32_bf16 v14, s26, v50, v14
    v_dot2_f32_bf16 v15, s26, v55, v15
    v_dot2_f32_bf16 v8, s27, v51, v8
    v_dot2_f32_bf16 v9, s27, v60, v9
    v_dot2_f32_bf16 v10, s27, v56, v10
    v_dot2_f32_bf16 v11, s27, v61, v11
    v_dot2_f32_bf16 v12, s27, v57, v12
    v_dot2_f32_bf16 v13, s27, v62, v13
    v_dot2_f32_bf16 v14, s27, v58, v14
    v_dot2_f32_bf16 v15, s27, v63, v15
    v_dot2_f32_bf16 v8, s28, v59, v8
    v_dot2_f32_bf16 v9, s28, v68, v9
    v_dot2_f32_bf16 v10, s28, v64, v10
    v_dot2_f32_bf16 v11, s28, v69, v11
    v_dot2_f32_bf16 v12, s28, v65, v12
    v_dot2_f32_bf16 v13, s28, v70, v13
    v_dot2_f32_bf16 v14, s28, v66, v14
    v_dot2_f32_bf16 v15, s28, v71, v15
    v_dot2_f32_bf16 v8, s29, v67, v8
    v_dot2_f32_bf16 v9, s29, v76, v9
    v_dot2_f32_bf16 v10, s29, v72, v10
    v_dot2_f32_bf16 v11, s29, v77, v11
    v_dot2_f32_bf16 v12, s29, v73, v12
    v_dot2_f32_bf16 v13, s29, v78, v13
    v_dot2_f32_bf16 v14, s29, v74, v14
    v_dot2_f32_bf16 v15, s29, v79, v15
    v_dot2_f32_bf16 v8, s30, v75, v8
    v_dot2_f32_bf16 v9, s30, v84, v9
    v_dot2_f32_bf16 v10, s30, v80, v10
    v_dot2_f32_bf16 v11, s30, v85, v11
    v_dot2_f32_bf16 v12, s30, v81, v12
    v_dot2_f32_bf16 v13, s30, v86, v13
    v_dot2_f32_bf16 v14, s30, v82, v14
    v_dot2_f32_bf16 v15, s30, v87, v15
    v_dot2_f32_bf16 v8, s31, v83, v8
    v_dot2_f32_bf16 v9, s31, v92, v9
    v_dot2_f32_bf16 v10, s31, v88, v10
    v_dot2_f32_bf16 v11, s31, v93, v11
    v_dot2_f32_bf16 v12, s31, v89, v12
    v_dot2_f32_bf16 v13, s31, v94, v13
    v_dot2_f32_bf16 v14, s31, v90, v14
    v_dot2_f32_bf16 v15, s31, v95, v15
    v_and_b32 v26, 63, v0
    v_lshlrev_b32 v26, 4, v26
    v_lshl_add_u32 v26, v25, 11, v26
    ds_write_b128 v26, v[8:11] offset:11264
    ds_write_b128 v26, v[12:15] offset:12288
    v_mov_b32 v30, v0
    v_lshlrev_b32 v27, 2, v30
    v_bfe_u32 v28, v30, 2, 6
    v_lshlrev_b32 v28, 5, v28
    v_lshrrev_b32 v29, 8, v30
    v_lshl_add_u32 v28, v29, 4, v28
    v_and_b32 v29, 3, v30
    v_lshl_add_u32 v28, v29, 2, v28
    s_waitcnt lgkmcnt(0)
    s_barrier
    ds_read_b32 v96, v27 offset:11264
    ds_read_b32 v97, v27 offset:13312
    ds_read_b32 v98, v27 offset:15360
    ds_read_b32 v99, v27 offset:17408
    ds_read_b32 v100, v27 offset:19456
    ds_read_b32 v101, v27 offset:21504
    ds_read_b32 v102, v27 offset:23552
    ds_read_b32 v103, v27 offset:25600
    s_waitcnt lgkmcnt(0)
    v_add_f32 v96, v96, v100
    v_add_f32 v97, v97, v101
    v_add_f32 v98, v98, v102
    v_add_f32 v99, v99, v103
    v_add_f32 v96, v96, v98
    v_add_f32 v97, v97, v99
    v_add_f32 v96, v96, v97
    buffer_store_dword v96, v28, s[44:47], s72 offen
    v_cmp_eq_u32 vcc, 448, v0
    s_nop 1
    s_and_saveexec_b64 s[80:81], vcc
    s_cbranch_execz L_k1_end
    v_mov_b32 v28, 0
    buffer_store_dwordx2 v[16:17], v28, s[44:47], s73 offen
L_k1_end:
    s_endpgm
.globl concat_heads_combine_kernel
.p2align 8
.type concat_heads_combine_kernel,@function
concat_heads_combine_kernel:
    s_cmp_ge_u32 s2, 32
    s_cbranch_scc1 L_k2_end
    s_load_dwordx2 s[4:5], s[0:1], 80
    s_load_dwordx2 s[6:7], s[0:1], 96
    s_lshr_b32 s3, s2, 4
    s_and_b32 s16, s2, 15
    s_lshl_b32 s17, s3, 18
    s_lshl_b32 s18, s16, 7
    s_add_u32 s17, s17, s18
    s_add_u32 s18, s17, 4096
    s_lshl_b32 s19, s3, 10
    s_add_u32 s19, s19, 524288
    s_lshl_b32 s20, s3, 10
    s_lshl_b32 s21, s16, 6
    s_add_u32 s20, s20, s21
    v_lshrrev_b32 v1, 3, v0
    v_and_b32 v2, 7, v0
    v_lshlrev_b32 v2, 4, v2
    v_lshl_add_u32 v2, v1, 13, v2
    v_lshlrev_b32 v3, 5, v1
    s_waitcnt lgkmcnt(0)
    s_mov_b32 s8, s6
    s_mov_b32 s9, s7
    s_mov_b32 s10, 526336
    s_mov_b32 s11, 0x00020000
    s_mov_b32 s12, s4
    s_mov_b32 s13, s5
    s_mov_b32 s14, 2048
    s_mov_b32 s15, 0x00020000
    buffer_load_dwordx4 v[4:7], v3, s[8:11], s19 offen
    buffer_load_dwordx4 v[8:11], v3, s[8:11], s19 offen offset:16
    buffer_load_dwordx4 v[12:15], v2, s[8:11], s17 offen
    buffer_load_dwordx4 v[16:19], v2, s[8:11], s17 offen offset:2048
    buffer_load_dwordx4 v[20:23], v2, s[8:11], s18 offen
    buffer_load_dwordx4 v[24:27], v2, s[8:11], s18 offen offset:2048
    s_waitcnt vmcnt(4)
    v_max_f32 v28, v4, v6
    v_max3_f32 v28, v8, v10, v28
    v_sub_f32 v4, v4, v28
    v_sub_f32 v6, v6, v28
    v_sub_f32 v8, v8, v28
    v_sub_f32 v10, v10, v28
    v_exp_f32 v4, v4
    v_exp_f32 v6, v6
    v_exp_f32 v8, v8
    v_exp_f32 v10, v10
    v_mul_f32 v29, v4, v5
    v_fma_f32 v29, v6, v7, v29
    v_fma_f32 v29, v8, v9, v29
    v_fma_f32 v29, v10, v11, v29
    v_rcp_f32 v29, v29
    s_nop 0
    v_mul_f32 v4, v4, v29
    v_mul_f32 v6, v6, v29
    v_mul_f32 v8, v8, v29
    v_mul_f32 v10, v10, v29
    s_waitcnt vmcnt(0)
    v_mul_f32 v12, v4, v12
    v_mul_f32 v13, v4, v13
    v_mul_f32 v14, v4, v14
    v_mul_f32 v15, v4, v15
    v_fma_f32 v12, v6, v16, v12
    v_fma_f32 v13, v6, v17, v13
    v_fma_f32 v14, v6, v18, v14
    v_fma_f32 v15, v6, v19, v15
    v_fma_f32 v12, v8, v20, v12
    v_fma_f32 v13, v8, v21, v13
    v_fma_f32 v14, v8, v22, v14
    v_fma_f32 v15, v8, v23, v15
    v_fma_f32 v12, v10, v24, v12
    v_fma_f32 v13, v10, v25, v13
    v_fma_f32 v14, v10, v26, v14
    v_fma_f32 v15, v10, v27, v15
    v_lshlrev_b32 v1, 4, v0
    ds_write_b128 v1, v[12:15]
    v_lshlrev_b32 v2, 2, v0
    v_lshlrev_b32 v3, 1, v0
    s_waitcnt lgkmcnt(0)
    s_barrier
    v_cmp_gt_u32 vcc, 32, v0
    s_nop 1
    s_and_saveexec_b64 s[22:23], vcc
    s_cbranch_execz L_k2_end
    ds_read_b32 v4, v2 offset:0
    ds_read_b32 v5, v2 offset:128
    ds_read_b32 v6, v2 offset:256
    ds_read_b32 v7, v2 offset:384
    ds_read_b32 v8, v2 offset:512
    ds_read_b32 v9, v2 offset:640
    ds_read_b32 v10, v2 offset:768
    ds_read_b32 v11, v2 offset:896
    ds_read_b32 v12, v2 offset:1024
    ds_read_b32 v13, v2 offset:1152
    ds_read_b32 v14, v2 offset:1280
    ds_read_b32 v15, v2 offset:1408
    ds_read_b32 v16, v2 offset:1536
    ds_read_b32 v17, v2 offset:1664
    ds_read_b32 v18, v2 offset:1792
    ds_read_b32 v19, v2 offset:1920
    ds_read_b32 v20, v2 offset:2048
    ds_read_b32 v21, v2 offset:2176
    ds_read_b32 v22, v2 offset:2304
    ds_read_b32 v23, v2 offset:2432
    ds_read_b32 v24, v2 offset:2560
    ds_read_b32 v25, v2 offset:2688
    ds_read_b32 v26, v2 offset:2816
    ds_read_b32 v27, v2 offset:2944
    ds_read_b32 v28, v2 offset:3072
    ds_read_b32 v29, v2 offset:3200
    ds_read_b32 v30, v2 offset:3328
    ds_read_b32 v31, v2 offset:3456
    ds_read_b32 v32, v2 offset:3584
    ds_read_b32 v33, v2 offset:3712
    ds_read_b32 v34, v2 offset:3840
    ds_read_b32 v35, v2 offset:3968
    s_waitcnt lgkmcnt(0)
    v_add_f32 v4, v4, v20
    v_add_f32 v5, v5, v21
    v_add_f32 v6, v6, v22
    v_add_f32 v7, v7, v23
    v_add_f32 v8, v8, v24
    v_add_f32 v9, v9, v25
    v_add_f32 v10, v10, v26
    v_add_f32 v11, v11, v27
    v_add_f32 v12, v12, v28
    v_add_f32 v13, v13, v29
    v_add_f32 v14, v14, v30
    v_add_f32 v15, v15, v31
    v_add_f32 v16, v16, v32
    v_add_f32 v17, v17, v33
    v_add_f32 v18, v18, v34
    v_add_f32 v19, v19, v35
    v_add_f32 v4, v4, v12
    v_add_f32 v5, v5, v13
    v_add_f32 v6, v6, v14
    v_add_f32 v7, v7, v15
    v_add_f32 v8, v8, v16
    v_add_f32 v9, v9, v17
    v_add_f32 v10, v10, v18
    v_add_f32 v11, v11, v19
    v_add_f32 v4, v4, v8
    v_add_f32 v5, v5, v9
    v_add_f32 v6, v6, v10
    v_add_f32 v7, v7, v11
    v_add_f32 v4, v4, v6
    v_add_f32 v5, v5, v7
    v_add_f32 v4, v4, v5
    v_cvt_pk_bf16_f32 v4, v4, 0
    buffer_store_short v4, v3, s[12:15], s20 offen
L_k2_end:
    s_endpgm
.section .rodata,"a"
.p2align 6
.amdhsa_kernel concat_heads__mha_block_cached__gqa_block_cached__decode_kernel
  .amdhsa_next_free_vgpr 256
  .amdhsa_next_free_sgpr 102
  .amdhsa_accum_offset 256
  .amdhsa_group_segment_fixed_size 0
  .amdhsa_kernarg_size 104
  .amdhsa_user_sgpr_count 2
  .amdhsa_user_sgpr_kernarg_segment_ptr 1
  .amdhsa_system_sgpr_workgroup_id_x 1
.end_amdhsa_kernel
.p2align 6
.amdhsa_kernel concat_heads_combine_kernel
  .amdhsa_next_free_vgpr 40
  .amdhsa_next_free_sgpr 32
  .amdhsa_accum_offset 40
  .amdhsa_group_segment_fixed_size 0
  .amdhsa_kernarg_size 104
  .amdhsa_user_sgpr_count 2
  .amdhsa_user_sgpr_kernarg_segment_ptr 1
  .amdhsa_system_sgpr_workgroup_id_x 1
.end_amdhsa_kernel
```
